```python
import torch

def _softmax(x, axis=-1):
    return torch.softmax(x, dim=axis)
def _gelu(x):
    return torch.nn.functional.gelu(x, approximate="tanh")
def _silu(x):
    return torch.nn.functional.silu(x)
def _sigmoid(x):
    return torch.sigmoid(x)
def _layernorm(x, axis=-1, eps=1e-5):
    m = x.mean(dim=axis, keepdim=True)
    v = x.var(dim=axis, keepdim=True, unbiased=False)
    return (x - m) / torch.sqrt(v + eps)
def _scatter_add(tgt, idx, src, axis=0):
    return tgt.clone().index_add_(axis, idx, src)
def _segment_sum(src, seg, n):
    out = torch.zeros((n,) + src.shape[1:], dtype=src.dtype)
    return out.index_add_(0, seg, src)
def _pad(x, pw):
    flat = tuple(v for pair in reversed(pw) for v in pair)
    return torch.nn.functional.pad(x, flat)

kernel_name = 'standalone__normalfloat_lut_codebook_lookup__prompt'

def setup_inputs():

    _w = (lambda a: (lambda t: t.to(torch.bfloat16) if t.is_floating_point() else t)(torch.as_tensor(a)))
    B, S, D, F = 1, 2048, 1024, 3584
    G = 128 if 128 > 0 else D
    D = (D // G) * G
    ng = D // G
    nf4 = torch.tensor([
        -1.0, -0.6961928009986877, -0.5250730514526367, -0.39491748809814453,
        -0.28444138169288635, -0.18477343022823334, -0.09105003625154495, 0.0,
        0.07958029955625534, 0.16093020141124725, 0.24611230194568634, 0.33791524171829224,
        0.44070982933044434, 0.5626170039176941, 0.7229568362236023, 1.0
    ], dtype=float)
    qw = torch.randint(0, 16, (D, F)).to(torch.int64)
    absmax = (torch.abs((lambda *s: torch.randn(*s, dtype=torch.bfloat16) * 0.05)(ng, F)) + 0.01).to(float)
    return {
        "x": _w((lambda *s: torch.randn(*s, dtype=torch.bfloat16) * 0.05)(B, S, D)),
        "qw": _w(qw),
        "codebook": _w(nf4),
        "absmax": _w(absmax),
    }

def reference(x, qw, codebook, absmax):
    B, S, D = x.shape
    ng, F = absmax.shape
    G = D // ng
    w_nf = codebook[qw]
    s = (lambda x, n, axis: torch.repeat_interleave(x, n, dim=axis))(absmax, G, axis=0)
    w = (lambda x, dt: x.to(dt))(w_nf * s, x.dtype)
    return torch.einsum("bsd,df->bsf", x, w)
```

```asm
; @launch grid=(256,1,1) block=(512,1,1) lds=159296
.amdgcn_target "amdgcn-amd-amdhsa--gfx950"
.text
.globl standalone__normalfloat_lut_codebook_lookup__prompt_kernel
.p2align 8
.type standalone__normalfloat_lut_codebook_lookup__prompt_kernel,@function
standalone__normalfloat_lut_codebook_lookup__prompt_kernel:
    s_load_dwordx8 s[4:11], s[0:1], 0
    s_load_dwordx2 s[12:13], s[0:1], 32
    s_load_dwordx4 s[36:39], s[0:1], 40
    s_cmp_ge_u32 s2, 256
    s_cbranch_scc1 L_end
    v_lshrrev_b32 v1, 6, v0
    v_and_b32 v0, 63, v0
    v_readfirstlane_b32 s14, v1
    s_bfe_u32 s81, s2, 0x30003
    s_and_b32 s65, s2, 7
    s_lshl_b32 s65, s65, 2
    s_lshr_b32 s82, s2, 6
    s_add_u32 s82, s82, s65
    s_lshl_b32 s56, s81, 8
    s_mul_i32 s57, s82, 112
    s_and_b32 s15, s14, 3
    s_lshr_b32 s61, s14, 2
    v_and_b32 v6, 31, v0
    v_cmp_gt_u32 vcc, 28, v6
    v_subrev_u32 v12, 4, v6
    s_lshl_b32 s65, s15, 1
    v_lshrrev_b32 v7, 5, v0
    v_cndmask_b32 v6, v12, v6, vcc
    v_add_u32 v7, s65, v7
    s_mov_b32 s71, 114688
    v_mul_lo_u32 v8, v7, s71
    v_lshl_add_u32 v8, v6, 4, v8
    v_mov_b32 v9, 0
    v_lshlrev_b32 v65, 3, v6
    s_lshl_b32 s73, s81, 1
    s_add_u32 s73, s73, s61
    s_mul_i32 s59, s73, 917504
    s_lshl_b32 s65, s57, 2
    s_add_u32 s59, s59, s65
    s_lshl_b32 s65, s82, 8
    s_add_u32 s84, s65, 7340032
    s_cmp_eq_u32 s61, 0
    s_cbranch_scc0 L_load
    s_setprio 3
    s_mul_i32 s75, s81, 7168
    s_add_u32 s65, s57, s15
    s_lshl_b32 s65, s65, 1
    s_add_u32 s75, s75, s65
    s_waitcnt lgkmcnt(0)
    s_mov_b32 s24, s10
    s_and_b32 s25, s11, 0xffff
    s_mov_b32 s26, 57344
    s_mov_b32 s27, 0x20000
    s_load_dwordx8 s[88:95], s[8:9], 0
    buffer_load_ushort v218, v65, s[24:27], s75 offen
    s_mov_b32 s20, s6
    s_and_b32 s21, s7, 0xffff
    s_mov_b32 s22, 14680064
    s_mov_b32 s23, 0x74fac
    buffer_load_format_d16_xyzw v[48:49], v8, s[20:23], s59 offen
    s_add_u32 s59, s59, 14336
    buffer_load_format_d16_xyzw v[50:51], v8, s[20:23], s59 offen
    s_add_u32 s59, s59, 14336
    buffer_load_format_d16_xyzw v[52:53], v8, s[20:23], s59 offen
    s_add_u32 s59, s59, 14336
    buffer_load_format_d16_xyzw v[54:55], v8, s[20:23], s59 offen
    s_add_u32 s59, s59, 14336
    buffer_load_format_d16_xyzw v[56:57], v8, s[20:23], s59 offen
    s_add_u32 s59, s59, 14336
    buffer_load_format_d16_xyzw v[58:59], v8, s[20:23], s59 offen
    s_add_u32 s59, s59, 14336
    buffer_load_format_d16_xyzw v[60:61], v8, s[20:23], s59 offen
    s_add_u32 s59, s59, 14336
    buffer_load_format_d16_xyzw v[62:63], v8, s[20:23], s59 offen
    s_mov_b32 s32, s38
    s_and_b32 s33, s39, 0xffff
    s_mov_b32 s34, 7348224
    s_mov_b32 s35, 0x20000
    buffer_load_dwordx2 v[252:253], v9, s[32:35], s84 offen offset:128
    s_barrier
    s_mov_b32 s28, s12
    s_and_b32 s29, s13, 0xffff
    s_mov_b32 s30, 14680064
    s_mov_b32 s31, 0x20000
    s_mov_b32 s16, s4
    s_and_b32 s17, s5, 0xffff
    s_mov_b32 s18, 4194304
    s_mov_b32 s19, 0x20000
    v_mul_u32_u24 v11, 1792, v7
    v_lshrrev_b32 v12, 2, v6
    v_lshl_add_u32 v11, v12, 8, v11
    v_and_b32 v12, 3, v6
    v_lshl_add_u32 v11, v12, 4, v11
    s_mul_i32 s85, s82, 229376
    s_mul_i32 s59, s73, 14336
    s_add_u32 s59, s59, s85
    s_mul_i32 s65, s15, 3584
    s_add_u32 s59, s59, s65
    s_lshr_b32 s71, s14, 2
    s_mul_i32 s71, s71, 47104
    s_add_u32 s65, s65, s71
    s_add_u32 s65, s65, 32768
    v_lshlrev_b32 v67, 4, v0
    v_add_u32 v66, s65, v67
    v_lshlrev_b32 v12, 4, v6
    v_add_u32 v12, 141376, v12
    s_mov_b32 s62, 0x05010400
    s_mov_b32 s63, 0x07030602
    s_mov_b32 s64, 0x08080808
    s_mov_b32 s69, 0x05040100
    s_mov_b32 s3, 0x07060302
    s_mov_b32 s78, 0x06040200
    s_mov_b32 s79, 0x07050301
    s_mov_b32 s75, 0x0b0a0c0c
    s_mov_b32 s76, 0x0c0c090c
    s_mov_b32 s77, 0x0c0c0c08
    s_mov_b32 s80, 0xffffff00
    v_lshrrev_b32 v220, 3, v0
    v_and_b32 v221, 7, v0
    v_lshrrev_b32 v222, 4, v0
    v_xor_b32 v221, v221, v222
    v_lshlrev_b32 v221, 4, v221
    v_lshl_add_u32 v221, v220, 11, v221
    v_xor_b32 v222, 64, v221
    v_add_u32 v68, 0, v221
    v_add_u32 v69, 15360, v222
    v_add_u32 v70, 30720, v221
    v_add_u32 v71, 46080, v222
    v_add_u32 v72, 65536, v221
    v_add_u32 v73, 80896, v222
    v_add_u32 v74, 96256, v221
    v_add_u32 v75, 111616, v222
    s_lshl_b32 s72, s15, 13
    s_lshl_b32 s83, s15, 6
    s_add_u32 s83, s83, s56
    s_lshl_b32 s83, s83, 11
    s_add_u32 s58, s83, s56
    s_mov_b32 m0, s72
    v_mov_b32 v13, 141312
    v_add_u32 v10, 32768, v11
    s_mul_i32 s65, s15, 896
    v_add_u32 v64, s65, v12
    v_mov_b32 v14, 0
    v_mov_b32 v15, 0
    ds_write_b32 v13, v14
    v_and_b32 v221, 15, v0
    v_lshrrev_b32 v222, 4, v0
    v_mul_u32_u24 v4, 1792, v222
    v_and_b32 v220, 3, v0
    v_lshl_add_u32 v4, v220, 6, v4
    v_bfe_u32 v220, v0, 2, 2
    v_lshl_add_u32 v4, v220, 4, v4
    v_add_u32 v4, 32768, v4
    v_add_u32 v5, 7168, v4
    v_lshrrev_b32 v220, 1, v221
    v_xor_b32 v222, v222, v220
    v_lshlrev_b32 v222, 4, v222
    v_lshl_add_u32 v222, v221, 7, v222
    s_lshl_b32 s65, s15, 13
    v_add_u32 v2, s65, v222
    v_xor_b32 v3, 64, v2
    v_pk_mov_b32 v[104:105], v[14:15], v[14:15]
    v_pk_mov_b32 v[106:107], v[14:15], v[14:15]
    v_pk_mov_b32 v[108:109], v[14:15], v[14:15]
    v_pk_mov_b32 v[110:111], v[14:15], v[14:15]
    v_pk_mov_b32 v[112:113], v[14:15], v[14:15]
    v_pk_mov_b32 v[114:115], v[14:15], v[14:15]
    v_pk_mov_b32 v[116:117], v[14:15], v[14:15]
    v_pk_mov_b32 v[118:119], v[14:15], v[14:15]
    v_pk_mov_b32 v[120:121], v[14:15], v[14:15]
    v_pk_mov_b32 v[122:123], v[14:15], v[14:15]
    v_pk_mov_b32 v[124:125], v[14:15], v[14:15]
    v_pk_mov_b32 v[126:127], v[14:15], v[14:15]
    v_pk_mov_b32 v[128:129], v[14:15], v[14:15]
    v_pk_mov_b32 v[130:131], v[14:15], v[14:15]
    v_pk_mov_b32 v[132:133], v[14:15], v[14:15]
    v_pk_mov_b32 v[134:135], v[14:15], v[14:15]
    v_pk_mov_b32 v[136:137], v[14:15], v[14:15]
    v_pk_mov_b32 v[138:139], v[14:15], v[14:15]
    v_pk_mov_b32 v[140:141], v[14:15], v[14:15]
    v_pk_mov_b32 v[142:143], v[14:15], v[14:15]
    v_pk_mov_b32 v[144:145], v[14:15], v[14:15]
    v_pk_mov_b32 v[146:147], v[14:15], v[14:15]
    v_pk_mov_b32 v[148:149], v[14:15], v[14:15]
    v_pk_mov_b32 v[150:151], v[14:15], v[14:15]
    v_pk_mov_b32 v[152:153], v[14:15], v[14:15]
    v_pk_mov_b32 v[154:155], v[14:15], v[14:15]
    v_pk_mov_b32 v[156:157], v[14:15], v[14:15]
    v_pk_mov_b32 v[158:159], v[14:15], v[14:15]
    v_pk_mov_b32 v[160:161], v[14:15], v[14:15]
    v_pk_mov_b32 v[162:163], v[14:15], v[14:15]
    v_pk_mov_b32 v[164:165], v[14:15], v[14:15]
    v_pk_mov_b32 v[166:167], v[14:15], v[14:15]
    v_pk_mov_b32 v[168:169], v[14:15], v[14:15]
    v_pk_mov_b32 v[170:171], v[14:15], v[14:15]
    v_pk_mov_b32 v[172:173], v[14:15], v[14:15]
    v_pk_mov_b32 v[174:175], v[14:15], v[14:15]
    v_pk_mov_b32 v[176:177], v[14:15], v[14:15]
    v_pk_mov_b32 v[178:179], v[14:15], v[14:15]
    v_pk_mov_b32 v[180:181], v[14:15], v[14:15]
    v_pk_mov_b32 v[182:183], v[14:15], v[14:15]
    v_pk_mov_b32 v[184:185], v[14:15], v[14:15]
    v_pk_mov_b32 v[186:187], v[14:15], v[14:15]
    v_pk_mov_b32 v[188:189], v[14:15], v[14:15]
    v_pk_mov_b32 v[190:191], v[14:15], v[14:15]
    v_pk_mov_b32 v[192:193], v[14:15], v[14:15]
    v_pk_mov_b32 v[194:195], v[14:15], v[14:15]
    v_pk_mov_b32 v[196:197], v[14:15], v[14:15]
    v_pk_mov_b32 v[198:199], v[14:15], v[14:15]
    v_pk_mov_b32 v[200:201], v[14:15], v[14:15]
    v_pk_mov_b32 v[202:203], v[14:15], v[14:15]
    v_pk_mov_b32 v[204:205], v[14:15], v[14:15]
    v_pk_mov_b32 v[206:207], v[14:15], v[14:15]
    v_pk_mov_b32 v[208:209], v[14:15], v[14:15]
    v_pk_mov_b32 v[210:211], v[14:15], v[14:15]
    v_pk_mov_b32 v[212:213], v[14:15], v[14:15]
    v_pk_mov_b32 v[214:215], v[14:15], v[14:15]
    s_mov_b32 s68, 47104
    s_mov_b32 s70, 47104
    s_getreg_b32 s60, hwreg(HW_REG_XCC_ID, 0, 4)
    s_mov_b32 s67, 0
    s_waitcnt lgkmcnt(0)
    s_lshl_b32 s40, s88, 16
    s_and_b32 s41, s88, 0xffff0000
    s_lshl_b32 s42, s89, 16
    s_and_b32 s43, s89, 0xffff0000
    s_lshl_b32 s44, s90, 16
    s_and_b32 s45, s90, 0xffff0000
    s_lshl_b32 s46, s91, 16
    s_and_b32 s47, s91, 0xffff0000
    s_lshl_b32 s48, s92, 16
    s_and_b32 s49, s92, 0xffff0000
    s_lshl_b32 s50, s93, 16
    s_and_b32 s51, s93, 0xffff0000
    s_lshl_b32 s52, s94, 16
    s_and_b32 s53, s94, 0xffff0000
    s_lshl_b32 s54, s95, 16
    s_and_b32 s55, s95, 0xffff0000
    s_waitcnt vmcnt(9)
L_tb:
    v_lshlrev_b32 v250, 16, v218
    v_pk_mul_f32 v[220:221], s[40:41], v[250:251] op_sel_hi:[1,0]
    v_pk_mul_f32 v[222:223], s[42:43], v[250:251] op_sel_hi:[1,0]
    v_pk_mul_f32 v[224:225], s[44:45], v[250:251] op_sel_hi:[1,0]
    v_pk_mul_f32 v[226:227], s[46:47], v[250:251] op_sel_hi:[1,0]
    v_pk_mul_f32 v[228:229], s[48:49], v[250:251] op_sel_hi:[1,0]
    v_pk_mul_f32 v[230:231], s[50:51], v[250:251] op_sel_hi:[1,0]
    v_pk_mul_f32 v[232:233], s[52:53], v[250:251] op_sel_hi:[1,0]
    v_pk_mul_f32 v[234:235], s[54:55], v[250:251] op_sel_hi:[1,0]
    v_cvt_pk_bf16_f32 v236, v220, v221
    v_cvt_pk_bf16_f32 v237, v222, v223
    v_cvt_pk_bf16_f32 v238, v224, v225
    v_cvt_pk_bf16_f32 v239, v226, v227
    v_cvt_pk_bf16_f32 v240, v228, v229
    v_cvt_pk_bf16_f32 v241, v230, v231
    v_cvt_pk_bf16_f32 v242, v232, v233
    v_cvt_pk_bf16_f32 v243, v234, v235
    v_perm_b32 v16, v237, v236, s78
    v_perm_b32 v20, v237, v236, s79
    v_perm_b32 v17, v239, v238, s78
    v_perm_b32 v21, v239, v238, s79
    v_perm_b32 v18, v241, v240, s78
    v_perm_b32 v22, v241, v240, s79
    v_perm_b32 v19, v243, v242, s78
    v_perm_b32 v23, v243, v242, s79
    v_xor_b32 v17, s80, v17
    v_xor_b32 v19, s80, v19
    v_xor_b32 v21, s80, v21
    v_xor_b32 v23, s80, v23
    v_perm_b32 v244, v19, v18, s75
    v_perm_b32 v245, v17, v16, s75
    v_perm_b32 v246, v23, v22, s75
    v_perm_b32 v247, v21, v20, s75
    v_xor_b32 v16, v244, v16
    v_xor_b32 v18, v245, v18
    v_xor_b32 v20, v246, v20
    v_xor_b32 v22, v247, v22
    v_perm_b32 v244, v19, v18, s76
    v_perm_b32 v245, v17, v16, s76
    v_perm_b32 v246, v23, v22, s76
    v_perm_b32 v247, v21, v20, s76
    v_xor_b32 v16, v244, v16
    v_xor_b32 v18, v245, v18
    v_xor_b32 v20, v246, v20
    v_xor_b32 v22, v247, v22
    v_perm_b32 v244, v19, v18, s77
    v_perm_b32 v245, v17, v16, s77
    v_perm_b32 v246, v23, v22, s77
    v_perm_b32 v247, v21, v20, s77
    v_xor_b32 v16, v244, v16
    v_xor_b32 v18, v245, v18
    v_xor_b32 v20, v246, v20
    v_xor_b32 v22, v247, v22
    ds_write_b128 v64, v[16:19]
    ds_write_b128 v64, v[20:23] offset:448
    s_cmp_eq_u32 s67, 2
    s_cbranch_scc1 L_fbt
    s_waitcnt lgkmcnt(0)
    s_barrier
    ds_read_b128 v[16:19], v12 offset:0
    ds_read_b128 v[20:23], v12 offset:448
    ds_read_b128 v[24:27], v12 offset:896
    ds_read_b128 v[28:31], v12 offset:1344
    ds_read_b128 v[32:35], v12 offset:1792
    ds_read_b128 v[36:39], v12 offset:2240
    ds_read_b128 v[40:43], v12 offset:2688
    ds_read_b128 v[44:47], v12 offset:3136
    s_mov_b32 s61, 0
    s_waitcnt vmcnt(1) lgkmcnt(0)
L_dq:
    v_lshl_or_b32 v236, v50, 8, v48
    v_lshl_or_b32 v237, v54, 8, v52
    v_lshl_or_b32 v238, v51, 8, v49
    v_lshl_or_b32 v239, v55, 8, v53
    v_perm_b32 v80, v237, v236, s69
    v_perm_b32 v82, v237, v236, s3
    v_perm_b32 v84, v239, v238, s69
    v_perm_b32 v86, v239, v238, s3
    v_lshl_or_b32 v236, v58, 8, v56
    v_lshl_or_b32 v237, v62, 8, v60
    v_lshl_or_b32 v238, v59, 8, v57
    v_lshl_or_b32 v239, v63, 8, v61
    v_perm_b32 v81, v237, v236, s69
    v_perm_b32 v83, v237, v236, s3
    v_perm_b32 v85, v239, v238, s69
    v_perm_b32 v87, v239, v238, s3
    v_xor_b32 v236, s64, v80
    v_perm_b32 v237, v17, v16, v80
    v_perm_b32 v239, v21, v20, v80
    v_perm_b32 v238, v19, v18, v236
    v_perm_b32 v240, v23, v22, v236
    v_xor_b32 v244, s64, v81
    v_perm_b32 v245, v17, v16, v81
    v_perm_b32 v247, v21, v20, v81
    v_perm_b32 v246, v19, v18, v244
    v_perm_b32 v248, v23, v22, v244
    v_xor_b32 v237, v237, v238
    v_xor_b32 v239, v239, v240
    v_xor_b32 v245, v245, v246
    v_xor_b32 v247, v247, v248
    v_perm_b32 v88, v239, v237, s62
    v_perm_b32 v89, v239, v237, s63
    v_perm_b32 v90, v247, v245, s62
    v_perm_b32 v91, v247, v245, s63
    ds_write_b128 v10, v[88:91] offset:0
    v_xor_b32 v236, s64, v82
    v_perm_b32 v237, v25, v24, v82
    v_perm_b32 v239, v29, v28, v82
    v_perm_b32 v238, v27, v26, v236
    v_perm_b32 v240, v31, v30, v236
    v_xor_b32 v244, s64, v83
    v_perm_b32 v245, v25, v24, v83
    v_perm_b32 v247, v29, v28, v83
    v_perm_b32 v246, v27, v26, v244
    v_perm_b32 v248, v31, v30, v244
    v_xor_b32 v237, v237, v238
    v_xor_b32 v239, v239, v240
    v_xor_b32 v245, v245, v246
    v_xor_b32 v247, v247, v248
    v_perm_b32 v92, v239, v237, s62
    v_perm_b32 v93, v239, v237, s63
    v_perm_b32 v94, v247, v245, s62
    v_perm_b32 v95, v247, v245, s63
    ds_write_b128 v10, v[92:95] offset:64
    v_xor_b32 v236, s64, v84
    v_perm_b32 v237, v33, v32, v84
    v_perm_b32 v239, v37, v36, v84
    v_perm_b32 v238, v35, v34, v236
    v_perm_b32 v240, v39, v38, v236
    v_xor_b32 v244, s64, v85
    v_perm_b32 v245, v33, v32, v85
    v_perm_b32 v247, v37, v36, v85
    v_perm_b32 v246, v35, v34, v244
    v_perm_b32 v248, v39, v38, v244
    v_xor_b32 v237, v237, v238
    v_xor_b32 v239, v239, v240
    v_xor_b32 v245, v245, v246
    v_xor_b32 v247, v247, v248
    v_perm_b32 v96, v239, v237, s62
    v_perm_b32 v97, v239, v237, s63
    v_perm_b32 v98, v247, v245, s62
    v_perm_b32 v99, v247, v245, s63
    ds_write_b128 v10, v[96:99] offset:128
    v_xor_b32 v236, s64, v86
    v_perm_b32 v237, v41, v40, v86
    v_perm_b32 v239, v45, v44, v86
    v_perm_b32 v238, v43, v42, v236
    v_perm_b32 v240, v47, v46, v236
    v_xor_b32 v244, s64, v87
    v_perm_b32 v245, v41, v40, v87
    v_perm_b32 v247, v45, v44, v87
    v_perm_b32 v246, v43, v42, v244
    v_perm_b32 v248, v47, v46, v244
    v_xor_b32 v237, v237, v238
    v_xor_b32 v239, v239, v240
    v_xor_b32 v245, v245, v246
    v_xor_b32 v247, v247, v248
    v_perm_b32 v100, v239, v237, s62
    v_perm_b32 v101, v239, v237, s63
    v_perm_b32 v102, v247, v245, s62
    v_perm_b32 v103, v247, v245, s63
    ds_write_b128 v10, v[100:103] offset:192
    s_cmp_eq_u32 s67, 2
    s_cbranch_scc1 L_fbd
    ds_read_b128 v[16:19], v66 offset:0
    ds_read_b128 v[20:23], v66 offset:1024
    ds_read_b128 v[24:27], v66 offset:2048
    ds_read_b128 v[28:31], v66 offset:3072
    s_cmp_eq_u32 s67, 1
    s_cbranch_scc1 L_ldq
    s_waitcnt lgkmcnt(3)
    buffer_store_dwordx4 v[16:19], v67, s[32:35], s59 offen offset:0
    s_waitcnt lgkmcnt(2)
    buffer_store_dwordx4 v[20:23], v67, s[32:35], s59 offen offset:1024
    s_waitcnt lgkmcnt(1)
    buffer_store_dwordx4 v[24:27], v67, s[32:35], s59 offen offset:2048
    s_waitcnt lgkmcnt(0)
    s_mov_b32 exec_hi, 0
    buffer_store_dwordx4 v[28:31], v67, s[32:35], s59 offen offset:3072
    s_mov_b32 exec_hi, -1
    s_lshl_b32 s75, s73, 3
    s_add_u32 s75, s75, s84
    v_mov_b32 v14, 1
    buffer_load_dwordx4 v68, s[16:19], s58 offen offset:0  lds
    buffer_load_dwordx4 v69, s[16:19], s58 offen offset:1024  lds
    buffer_load_dwordx4 v70, s[16:19], s58 offen offset:2048  lds
    buffer_load_dwordx4 v71, s[16:19], s58 offen offset:3072  lds
    s_add_u32 m0, m0, 4096
    s_nop 0
    buffer_load_dwordx4 v72, s[16:19], s58 offen offset:0  lds
    buffer_load_dwordx4 v73, s[16:19], s58 offen offset:1024  lds
    buffer_load_dwordx4 v74, s[16:19], s58 offen offset:2048  lds
    buffer_load_dwordx4 v75, s[16:19], s58 offen offset:3072  lds
    s_waitcnt vmcnt(12)
    s_mov_b32 s65, 0x9e3779b1
    s_mov_b32 s71, 0x85ebca77
    v_mul_lo_u32 v254, v252, s65
    v_mul_lo_u32 v255, v253, s71
    v_add_u32 v254, 0x7f4a7c15, v254
    v_add_u32 v255, 0x165667b1, v255
    v_alignbit_b32 v252, v254, v254, 13
    v_xor_b32 v253, v255, v252
    v_xor_b32 v252, v252, v255
    v_and_b32 v252, -16, v252
    v_or_b32 v252, s60, v252
    s_waitcnt vmcnt(8)
    s_mov_b64 exec, 1
    ds_add_rtn_u32 v15, v13, v14
    s_waitcnt lgkmcnt(0)
    v_cmp_eq_u32 vcc, 3, v15
    s_cbranch_vccz L_nofa
    buffer_store_dwordx2 v[252:253], v9, s[32:35], s75 offen
L_nofa:
    s_mov_b64 exec, -1
    s_add_u32 m0, s72, 47104
    s_add_u32 s58, s58, 128
    buffer_load_dwordx4 v68, s[16:19], s58 offen offset:0  lds
    buffer_load_dwordx4 v69, s[16:19], s58 offen offset:1024  lds
    buffer_load_dwordx4 v70, s[16:19], s58 offen offset:2048  lds
    buffer_load_dwordx4 v71, s[16:19], s58 offen offset:3072  lds
    s_add_u32 m0, m0, 4096
    s_nop 0
    buffer_load_dwordx4 v72, s[16:19], s58 offen offset:0  lds
    buffer_load_dwordx4 v73, s[16:19], s58 offen offset:1024  lds
    buffer_load_dwordx4 v74, s[16:19], s58 offen offset:2048  lds
    buffer_load_dwordx4 v75, s[16:19], s58 offen offset:3072  lds
    s_setprio 2
    s_barrier
    s_waitcnt vmcnt(8)
    ds_read_b128 v[16:19], v2 offset:0
    ds_read_b128 v[20:23], v2 offset:2048
    ds_read_b128 v[24:27], v2 offset:4096
    ds_read_b128 v[28:31], v2 offset:6144
    ds_read_b128 v[32:35], v4 offset:0
    ds_read_b128 v[36:39], v4 offset:256
    ds_read_b128 v[40:43], v4 offset:512
    ds_read_b128 v[44:47], v4 offset:768
    ds_read_b128 v[48:51], v4 offset:1024
    ds_read_b128 v[52:55], v4 offset:1280
    ds_read_b128 v[56:59], v4 offset:1536
    v_add_u32 v2, s68, v2
    v_add_u32 v4, s68, v4
.p2align 6
L_cloop:
    s_waitcnt lgkmcnt(0)
    v_mfma_f32_16x16x32_bf16 v[104:107], v[32:35], v[16:19], v[104:107]
    ds_read_b128 v[60:63], v3 offset:0
    v_mfma_f32_16x16x32_bf16 v[108:111], v[32:35], v[20:23], v[108:111]
    s_add_u32 s65, s70, 47104
    v_mfma_f32_16x16x32_bf16 v[112:115], v[32:35], v[24:27], v[112:115]
    ds_read_b128 v[64:67], v3 offset:2048
    v_mfma_f32_16x16x32_bf16 v[116:119], v[32:35], v[28:31], v[116:119]
    s_cmp_eq_u32 s65, 141312
    v_mfma_f32_16x16x32_bf16 v[120:123], v[36:39], v[16:19], v[120:123]
    ds_read_b128 v[68:71], v3 offset:4096
    v_mfma_f32_16x16x32_bf16 v[124:127], v[36:39], v[20:23], v[124:127]
    s_cselect_b32 s65, 0, s65
    v_mfma_f32_16x16x32_bf16 v[128:131], v[36:39], v[24:27], v[128:131]
    ds_read_b128 v[72:75], v3 offset:6144
    v_mfma_f32_16x16x32_bf16 v[132:135], v[36:39], v[28:31], v[132:135]
    v_mfma_f32_16x16x32_bf16 v[136:139], v[40:43], v[16:19], v[136:139]
    ds_read_b128 v[76:79], v5 offset:0
    v_mfma_f32_16x16x32_bf16 v[140:143], v[40:43], v[20:23], v[140:143]
    v_mfma_f32_16x16x32_bf16 v[144:147], v[40:43], v[24:27], v[144:147]
    ds_read_b128 v[80:83], v5 offset:256
    v_mfma_f32_16x16x32_bf16 v[148:151], v[40:43], v[28:31], v[148:151]
    v_mfma_f32_16x16x32_bf16 v[152:155], v[44:47], v[16:19], v[152:155]
    ds_read_b128 v[84:87], v5 offset:512
    v_mfma_f32_16x16x32_bf16 v[156:159], v[44:47], v[20:23], v[156:159]
    v_mfma_f32_16x16x32_bf16 v[160:163], v[44:47], v[24:27], v[160:163]
    ds_read_b128 v[88:91], v5 offset:768
    v_mfma_f32_16x16x32_bf16 v[164:167], v[44:47], v[28:31], v[164:167]
    v_mfma_f32_16x16x32_bf16 v[168:171], v[48:51], v[16:19], v[168:171]
    ds_read_b128 v[92:95], v5 offset:1024
    v_mfma_f32_16x16x32_bf16 v[172:175], v[48:51], v[20:23], v[172:175]
    v_mfma_f32_16x16x32_bf16 v[176:179], v[48:51], v[24:27], v[176:179]
    ds_read_b128 v[96:99], v5 offset:1280
    v_mfma_f32_16x16x32_bf16 v[180:183], v[48:51], v[28:31], v[180:183]
    v_mfma_f32_16x16x32_bf16 v[184:187], v[52:55], v[16:19], v[184:187]
    ds_read_b128 v[100:103], v5 offset:1536
    v_mfma_f32_16x16x32_bf16 v[188:191], v[52:55], v[20:23], v[188:191]
    v_mfma_f32_16x16x32_bf16 v[192:195], v[52:55], v[24:27], v[192:195]
    v_add_u32 v3, s68, v3
    v_mfma_f32_16x16x32_bf16 v[196:199], v[52:55], v[28:31], v[196:199]
    v_add_u32 v5, s68, v5
    v_mfma_f32_16x16x32_bf16 v[200:203], v[56:59], v[16:19], v[200:203]
    s_sub_u32 s68, s65, s70
    v_mfma_f32_16x16x32_bf16 v[204:207], v[56:59], v[20:23], v[204:207]
    s_mov_b32 s70, s65
    v_mfma_f32_16x16x32_bf16 v[208:211], v[56:59], v[24:27], v[208:211]
    v_mfma_f32_16x16x32_bf16 v[212:215], v[56:59], v[28:31], v[212:215]
    s_waitcnt vmcnt(0) lgkmcnt(0)
    s_barrier
    v_mfma_f32_16x16x32_bf16 v[104:107], v[76:79], v[60:63], v[104:107]
    ds_read_b128 v[16:19], v2 offset:0
    v_mfma_f32_16x16x32_bf16 v[108:111], v[76:79], v[64:67], v[108:111]
    v_mfma_f32_16x16x32_bf16 v[112:115], v[76:79], v[68:71], v[112:115]
    ds_read_b128 v[20:23], v2 offset:2048
    v_mfma_f32_16x16x32_bf16 v[116:119], v[76:79], v[72:75], v[116:119]
    v_mfma_f32_16x16x32_bf16 v[120:123], v[80:83], v[60:63], v[120:123]
    ds_read_b128 v[24:27], v2 offset:4096
    v_mfma_f32_16x16x32_bf16 v[124:127], v[80:83], v[64:67], v[124:127]
    v_mfma_f32_16x16x32_bf16 v[128:131], v[80:83], v[68:71], v[128:131]
    ds_read_b128 v[28:31], v2 offset:6144
    v_mfma_f32_16x16x32_bf16 v[132:135], v[80:83], v[72:75], v[132:135]
    v_mfma_f32_16x16x32_bf16 v[136:139], v[84:87], v[60:63], v[136:139]
    ds_read_b128 v[32:35], v4 offset:0
    v_mfma_f32_16x16x32_bf16 v[140:143], v[84:87], v[64:67], v[140:143]
    v_mfma_f32_16x16x32_bf16 v[144:147], v[84:87], v[68:71], v[144:147]
    ds_read_b128 v[36:39], v4 offset:256
    v_mfma_f32_16x16x32_bf16 v[148:151], v[84:87], v[72:75], v[148:151]
    v_mfma_f32_16x16x32_bf16 v[152:155], v[88:91], v[60:63], v[152:155]
    ds_read_b128 v[40:43], v4 offset:512
    v_mfma_f32_16x16x32_bf16 v[156:159], v[88:91], v[64:67], v[156:159]
    v_mfma_f32_16x16x32_bf16 v[160:163], v[88:91], v[68:71], v[160:163]
    ds_read_b128 v[44:47], v4 offset:768
    v_mfma_f32_16x16x32_bf16 v[164:167], v[88:91], v[72:75], v[164:167]
    v_mfma_f32_16x16x32_bf16 v[168:171], v[92:95], v[60:63], v[168:171]
    ds_read_b128 v[48:51], v4 offset:1024
    v_mfma_f32_16x16x32_bf16 v[172:175], v[92:95], v[64:67], v[172:175]
    v_mfma_f32_16x16x32_bf16 v[176:179], v[92:95], v[68:71], v[176:179]
    ds_read_b128 v[52:55], v4 offset:1280
    v_mfma_f32_16x16x32_bf16 v[180:183], v[92:95], v[72:75], v[180:183]
    v_mfma_f32_16x16x32_bf16 v[184:187], v[96:99], v[60:63], v[184:187]
    ds_read_b128 v[56:59], v4 offset:1536
    v_mfma_f32_16x16x32_bf16 v[188:191], v[96:99], v[64:67], v[188:191]
    v_mfma_f32_16x16x32_bf16 v[192:195], v[96:99], v[68:71], v[192:195]
    v_add_u32 v2, s68, v2
    v_mfma_f32_16x16x32_bf16 v[196:199], v[96:99], v[72:75], v[196:199]
    v_add_u32 v4, s68, v4
    v_mfma_f32_16x16x32_bf16 v[200:203], v[100:103], v[60:63], v[200:203]
    s_add_u32 s61, s61, 1
    v_mfma_f32_16x16x32_bf16 v[204:207], v[100:103], v[64:67], v[204:207]
    s_cmp_lt_u32 s61, 14
    v_mfma_f32_16x16x32_bf16 v[208:211], v[100:103], v[68:71], v[208:211]
    v_mfma_f32_16x16x32_bf16 v[212:215], v[100:103], v[72:75], v[212:215]
    s_cbranch_scc1 L_cloop
    s_waitcnt lgkmcnt(0)
    v_mfma_f32_16x16x32_bf16 v[104:107], v[32:35], v[16:19], v[104:107]
    ds_read_b128 v[60:63], v3 offset:0
    v_xor_b32 v6, 64, v3
    v_mfma_f32_16x16x32_bf16 v[108:111], v[32:35], v[20:23], v[108:111]
    ds_read_b128 v[64:67], v3 offset:2048
    v_xor_b32 v7, 64, v2
    v_mfma_f32_16x16x32_bf16 v[120:123], v[36:39], v[16:19], v[120:123]
    ds_read_b128 v[76:79], v5 offset:0
    v_subrev_u32 v8, 7168, v5
    v_mfma_f32_16x16x32_bf16 v[124:127], v[36:39], v[20:23], v[124:127]
    ds_read_b128 v[80:83], v5 offset:256
    v_and_b32 v9, 15, v0
    v_mfma_f32_16x16x32_bf16 v[136:139], v[40:43], v[16:19], v[136:139]
    ds_read_b128 v[84:87], v5 offset:512
    v_lshrrev_b32 v14, 4, v0
    v_mfma_f32_16x16x32_bf16 v[140:143], v[40:43], v[20:23], v[140:143]
    ds_read_b128 v[88:91], v5 offset:768
    v_mul_u32_u24 v9, 240, v9
    v_mfma_f32_16x16x32_bf16 v[152:155], v[44:47], v[16:19], v[152:155]
    ds_read_b128 v[92:95], v5 offset:1024
    v_lshl_add_u32 v9, v14, 3, v9
    v_mfma_f32_16x16x32_bf16 v[156:159], v[44:47], v[20:23], v[156:159]
    ds_read_b128 v[96:99], v5 offset:1280
    s_lshl_b32 s65, s15, 13
    v_mfma_f32_16x16x32_bf16 v[168:171], v[48:51], v[16:19], v[168:171]
    ds_read_b128 v[100:103], v5 offset:1536
    v_add_u32 v10, s65, v9
    v_mfma_f32_16x16x32_bf16 v[172:175], v[48:51], v[20:23], v[172:175]
    v_add_u32 v9, 47104, v10
    v_mfma_f32_16x16x32_bf16 v[184:187], v[52:55], v[16:19], v[184:187]
    v_mul_u32_u24 v14, 4682, v0
    v_mfma_f32_16x16x32_bf16 v[188:191], v[52:55], v[20:23], v[188:191]
    v_lshrrev_b32 v14, 16, v14
    v_mfma_f32_16x16x32_bf16 v[200:203], v[56:59], v[16:19], v[200:203]
    v_mul_u32_u24 v15, 14, v14
    v_mfma_f32_16x16x32_bf16 v[204:207], v[56:59], v[20:23], v[204:207]
    v_sub_u32 v15, v0, v15
    s_barrier
    s_waitcnt lgkmcnt(0)
    v_mfma_f32_16x16x32_bf16 v[104:107], v[76:79], v[60:63], v[104:107]
    ds_read_b128 v[16:19], v2 offset:0
    v_mul_u32_u24 v12, 240, v14
    v_mfma_f32_16x16x32_bf16 v[108:111], v[76:79], v[64:67], v[108:111]
    ds_read_b128 v[20:23], v2 offset:2048
    v_lshl_add_u32 v12, v15, 4, v12
    v_mfma_f32_16x16x32_bf16 v[120:123], v[80:83], v[60:63], v[120:123]
    ds_read_b128 v[32:35], v4 offset:0
    v_add_u32 v12, s65, v12
    v_mfma_f32_16x16x32_bf16 v[124:127], v[80:83], v[64:67], v[124:127]
    ds_read_b128 v[36:39], v4 offset:256
    v_add_u32 v11, 47104, v12
    v_mfma_f32_16x16x32_bf16 v[136:139], v[84:87], v[60:63], v[136:139]
    ds_read_b128 v[40:43], v4 offset:512
    v_mul_u32_u24 v13, 7168, v14
    v_mfma_f32_16x16x32_bf16 v[140:143], v[84:87], v[64:67], v[140:143]
    ds_read_b128 v[44:47], v4 offset:768
    v_lshl_add_u32 v13, v15, 4, v13
    v_mfma_f32_16x16x32_bf16 v[152:155], v[88:91], v[60:63], v[152:155]
    ds_read_b128 v[48:51], v4 offset:1024
    v_cmp_gt_u32 vcc, 56, v0
    v_mfma_f32_16x16x32_bf16 v[156:159], v[88:91], v[64:67], v[156:159]
    ds_read_b128 v[52:55], v4 offset:1280
    v_mov_b32 v14, 0x40000000
    v_mfma_f32_16x16x32_bf16 v[168:171], v[92:95], v[60:63], v[168:171]
    ds_read_b128 v[56:59], v4 offset:1536
    s_lshl_b32 s65, s15, 6
    v_mfma_f32_16x16x32_bf16 v[172:175], v[92:95], v[64:67], v[172:175]
    s_add_u32 s65, s65, s56
    v_mfma_f32_16x16x32_bf16 v[184:187], v[96:99], v[60:63], v[184:187]
    v_cndmask_b32 v13, v14, v13, vcc
    v_mfma_f32_16x16x32_bf16 v[188:191], v[96:99], v[64:67], v[188:191]
    s_mul_i32 s65, s65, 7168
    v_mfma_f32_16x16x32_bf16 v[200:203], v[100:103], v[60:63], v[200:203]
    s_lshl_b32 s71, s57, 1
    v_mfma_f32_16x16x32_bf16 v[204:207], v[100:103], v[64:67], v[204:207]
    s_add_u32 s65, s65, s71
    s_waitcnt lgkmcnt(0)
    v_mfma_f32_16x16x32_bf16 v[104:107], v[32:35], v[16:19], v[104:107]
    ds_read_b128 v[60:63], v7 offset:0
    v_mfma_f32_16x16x32_bf16 v[108:111], v[32:35], v[20:23], v[108:111]
    ds_read_b128 v[64:67], v7 offset:2048
    v_mfma_f32_16x16x32_bf16 v[120:123], v[36:39], v[16:19], v[120:123]
    ds_read_b128 v[76:79], v4 offset:7168
    v_mfma_f32_16x16x32_bf16 v[124:127], v[36:39], v[20:23], v[124:127]
    ds_read_b128 v[80:83], v4 offset:7424
    v_mfma_f32_16x16x32_bf16 v[136:139], v[40:43], v[16:19], v[136:139]
    ds_read_b128 v[84:87], v4 offset:7680
    v_mfma_f32_16x16x32_bf16 v[140:143], v[40:43], v[20:23], v[140:143]
    ds_read_b128 v[88:91], v4 offset:7936
    v_mfma_f32_16x16x32_bf16 v[152:155], v[44:47], v[16:19], v[152:155]
    ds_read_b128 v[92:95], v4 offset:8192
    v_mfma_f32_16x16x32_bf16 v[156:159], v[44:47], v[20:23], v[156:159]
    ds_read_b128 v[96:99], v4 offset:8448
    v_mfma_f32_16x16x32_bf16 v[168:171], v[48:51], v[16:19], v[168:171]
    ds_read_b128 v[100:103], v4 offset:8704
    v_mfma_f32_16x16x32_bf16 v[172:175], v[48:51], v[20:23], v[172:175]
    v_mfma_f32_16x16x32_bf16 v[184:187], v[52:55], v[16:19], v[184:187]
    v_mfma_f32_16x16x32_bf16 v[188:191], v[52:55], v[20:23], v[188:191]
    v_mfma_f32_16x16x32_bf16 v[200:203], v[56:59], v[16:19], v[200:203]
    v_mfma_f32_16x16x32_bf16 v[204:207], v[56:59], v[20:23], v[204:207]
    s_waitcnt lgkmcnt(0)
    v_mfma_f32_16x16x32_bf16 v[104:107], v[76:79], v[60:63], v[104:107]
    ds_read_b128 v[16:19], v6 offset:4096
    v_mfma_f32_16x16x32_bf16 v[108:111], v[76:79], v[64:67], v[108:111]
    ds_read_b128 v[20:23], v6 offset:6144
    v_mfma_f32_16x16x32_bf16 v[120:123], v[80:83], v[60:63], v[120:123]
    ds_read_b128 v[32:35], v8 offset:0
    v_mfma_f32_16x16x32_bf16 v[124:127], v[80:83], v[64:67], v[124:127]
    ds_read_b128 v[36:39], v8 offset:256
    v_mfma_f32_16x16x32_bf16 v[136:139], v[84:87], v[60:63], v[136:139]
    ds_read_b128 v[40:43], v8 offset:512
    v_mfma_f32_16x16x32_bf16 v[140:143], v[84:87], v[64:67], v[140:143]
    ds_read_b128 v[44:47], v8 offset:768
    v_mfma_f32_16x16x32_bf16 v[152:155], v[88:91], v[60:63], v[152:155]
    ds_read_b128 v[48:51], v8 offset:1024
    v_mfma_f32_16x16x32_bf16 v[156:159], v[88:91], v[64:67], v[156:159]
    ds_read_b128 v[52:55], v8 offset:1280
    v_mfma_f32_16x16x32_bf16 v[168:171], v[92:95], v[60:63], v[168:171]
    ds_read_b128 v[56:59], v8 offset:1536
    v_mfma_f32_16x16x32_bf16 v[172:175], v[92:95], v[64:67], v[172:175]
    v_mfma_f32_16x16x32_bf16 v[184:187], v[96:99], v[60:63], v[184:187]
    v_mfma_f32_16x16x32_bf16 v[188:191], v[96:99], v[64:67], v[188:191]
    v_mfma_f32_16x16x32_bf16 v[200:203], v[100:103], v[60:63], v[200:203]
    v_mfma_f32_16x16x32_bf16 v[204:207], v[100:103], v[64:67], v[204:207]
    s_waitcnt lgkmcnt(0)
    v_mfma_f32_16x16x32_bf16 v[112:115], v[32:35], v[16:19], v[112:115]
    ds_read_b128 v[60:63], v3 offset:4096
    v_mfma_f32_16x16x32_bf16 v[116:119], v[32:35], v[20:23], v[116:119]
    ds_read_b128 v[64:67], v3 offset:6144
    v_mfma_f32_16x16x32_bf16 v[128:131], v[36:39], v[16:19], v[128:131]
    ds_read_b128 v[76:79], v5 offset:0
    v_mfma_f32_16x16x32_bf16 v[132:135], v[36:39], v[20:23], v[132:135]
    ds_read_b128 v[80:83], v5 offset:256
    v_mfma_f32_16x16x32_bf16 v[144:147], v[40:43], v[16:19], v[144:147]
    ds_read_b128 v[84:87], v5 offset:512
    v_mfma_f32_16x16x32_bf16 v[148:151], v[40:43], v[20:23], v[148:151]
    ds_read_b128 v[88:91], v5 offset:768
    v_cvt_pk_bf16_f32 v216, v104, v105
    v_cvt_pk_bf16_f32 v217, v106, v107
    ds_write_b64 v9, v[216:217] offset:0
    v_mfma_f32_16x16x32_bf16 v[160:163], v[44:47], v[16:19], v[160:163]
    ds_read_b128 v[92:95], v5 offset:1024
    v_cvt_pk_bf16_f32 v218, v120, v121
    v_cvt_pk_bf16_f32 v219, v122, v123
    v_mfma_f32_16x16x32_bf16 v[164:167], v[44:47], v[20:23], v[164:167]
    ds_read_b128 v[96:99], v5 offset:1280
    ds_write_b64 v9, v[218:219] offset:32
    v_cvt_pk_bf16_f32 v220, v136, v137
    v_mfma_f32_16x16x32_bf16 v[176:179], v[48:51], v[16:19], v[176:179]
    ds_read_b128 v[100:103], v5 offset:1536
    v_cvt_pk_bf16_f32 v221, v138, v139
    ds_write_b64 v9, v[220:221] offset:64
    v_cvt_pk_bf16_f32 v222, v152, v153
    v_mfma_f32_16x16x32_bf16 v[180:183], v[48:51], v[20:23], v[180:183]
    v_cvt_pk_bf16_f32 v223, v154, v155
    ds_write_b64 v9, v[222:223] offset:96
    v_mfma_f32_16x16x32_bf16 v[192:195], v[52:55], v[16:19], v[192:195]
    v_cvt_pk_bf16_f32 v224, v168, v169
    v_cvt_pk_bf16_f32 v225, v170, v171
    v_mfma_f32_16x16x32_bf16 v[196:199], v[52:55], v[20:23], v[196:199]
    ds_write_b64 v9, v[224:225] offset:128
    v_cvt_pk_bf16_f32 v226, v184, v185
    v_cvt_pk_bf16_f32 v227, v186, v187
    v_mfma_f32_16x16x32_bf16 v[208:211], v[56:59], v[16:19], v[208:211]
    ds_write_b64 v9, v[226:227] offset:160
    v_cvt_pk_bf16_f32 v228, v200, v201
    v_mfma_f32_16x16x32_bf16 v[212:215], v[56:59], v[20:23], v[212:215]
    v_cvt_pk_bf16_f32 v229, v202, v203
    ds_write_b64 v9, v[228:229] offset:192
    s_waitcnt lgkmcnt(0)
    v_mfma_f32_16x16x32_bf16 v[112:115], v[76:79], v[60:63], v[112:115]
    ds_read_b128 v[16:19], v2 offset:4096
    v_cvt_pk_bf16_f32 v230, v108, v109
    v_cvt_pk_bf16_f32 v231, v110, v111
    v_mfma_f32_16x16x32_bf16 v[116:119], v[76:79], v[64:67], v[116:119]
    ds_read_b128 v[20:23], v2 offset:6144
    ds_write_b64 v9, v[230:231] offset:3840
    v_cvt_pk_bf16_f32 v232, v124, v125
    v_mfma_f32_16x16x32_bf16 v[128:131], v[80:83], v[60:63], v[128:131]
    ds_read_b128 v[32:35], v4 offset:0
    v_cvt_pk_bf16_f32 v233, v126, v127
    ds_write_b64 v9, v[232:233] offset:3872
    v_mfma_f32_16x16x32_bf16 v[132:135], v[80:83], v[64:67], v[132:135]
    ds_read_b128 v[36:39], v4 offset:256
    v_cvt_pk_bf16_f32 v234, v140, v141
    v_cvt_pk_bf16_f32 v235, v142, v143
    v_mfma_f32_16x16x32_bf16 v[144:147], v[84:87], v[60:63], v[144:147]
    ds_read_b128 v[40:43], v4 offset:512
    ds_write_b64 v9, v[234:235] offset:3904
    v_mfma_f32_16x16x32_bf16 v[148:151], v[84:87], v[64:67], v[148:151]
    ds_read_b128 v[44:47], v4 offset:768
    v_cvt_pk_bf16_f32 v236, v156, v157
    v_cvt_pk_bf16_f32 v237, v158, v159
    v_mfma_f32_16x16x32_bf16 v[160:163], v[88:91], v[60:63], v[160:163]
    ds_read_b128 v[48:51], v4 offset:1024
    ds_write_b64 v9, v[236:237] offset:3936
    v_cvt_pk_bf16_f32 v238, v172, v173
    v_mfma_f32_16x16x32_bf16 v[164:167], v[88:91], v[64:67], v[164:167]
    ds_read_b128 v[52:55], v4 offset:1280
    v_cvt_pk_bf16_f32 v239, v174, v175
    ds_write_b64 v9, v[238:239] offset:3968
    v_mfma_f32_16x16x32_bf16 v[176:179], v[92:95], v[60:63], v[176:179]
    ds_read_b128 v[56:59], v4 offset:1536
    v_cvt_pk_bf16_f32 v240, v188, v189
    v_cvt_pk_bf16_f32 v241, v190, v191
    v_mfma_f32_16x16x32_bf16 v[180:183], v[92:95], v[64:67], v[180:183]
    ds_write_b64 v9, v[240:241] offset:4000
    v_mfma_f32_16x16x32_bf16 v[192:195], v[96:99], v[60:63], v[192:195]
    v_cvt_pk_bf16_f32 v242, v204, v205
    v_cvt_pk_bf16_f32 v243, v206, v207
    v_mfma_f32_16x16x32_bf16 v[196:199], v[96:99], v[64:67], v[196:199]
    ds_write_b64 v9, v[242:243] offset:4032
    ds_read_b128 v[104:107], v11 offset:0
    v_mfma_f32_16x16x32_bf16 v[208:211], v[100:103], v[60:63], v[208:211]
    ds_read_b128 v[120:123], v11 offset:960
    ds_read_b128 v[136:139], v11 offset:1920
    v_mfma_f32_16x16x32_bf16 v[212:215], v[100:103], v[64:67], v[212:215]
    ds_read_b128 v[152:155], v11 offset:2880
    s_waitcnt lgkmcnt(0)
    v_mfma_f32_16x16x32_bf16 v[112:115], v[32:35], v[16:19], v[112:115]
    ds_read_b128 v[60:63], v7 offset:4096
    ds_read_b128 v[108:111], v11 offset:3840
    v_mfma_f32_16x16x32_bf16 v[116:119], v[32:35], v[20:23], v[116:119]
    ds_read_b128 v[64:67], v7 offset:6144
    ds_read_b128 v[124:127], v11 offset:4800
    v_mfma_f32_16x16x32_bf16 v[128:131], v[36:39], v[16:19], v[128:131]
    ds_read_b128 v[76:79], v4 offset:7168
    ds_read_b128 v[140:143], v11 offset:5760
    v_mfma_f32_16x16x32_bf16 v[132:135], v[36:39], v[20:23], v[132:135]
    ds_read_b128 v[80:83], v4 offset:7424
    ds_read_b128 v[156:159], v11 offset:6720
    v_mfma_f32_16x16x32_bf16 v[144:147], v[40:43], v[16:19], v[144:147]
    ds_read_b128 v[84:87], v4 offset:7680
    buffer_store_dwordx4 v[104:107], v13, s[28:31], s65 offen nt
    v_mfma_f32_16x16x32_bf16 v[148:151], v[40:43], v[20:23], v[148:151]
    ds_read_b128 v[88:91], v4 offset:7936
    s_add_u32 s65, s65, 28672
    v_mfma_f32_16x16x32_bf16 v[160:163], v[44:47], v[16:19], v[160:163]
    ds_read_b128 v[92:95], v4 offset:8192
    v_mfma_f32_16x16x32_bf16 v[164:167], v[44:47], v[20:23], v[164:167]
    ds_read_b128 v[96:99], v4 offset:8448
    buffer_store_dwordx4 v[120:123], v13, s[28:31], s65 offen nt
    v_mfma_f32_16x16x32_bf16 v[176:179], v[48:51], v[16:19], v[176:179]
    ds_read_b128 v[100:103], v4 offset:8704
    s_add_u32 s65, s65, 28672
    v_mfma_f32_16x16x32_bf16 v[180:183], v[48:51], v[20:23], v[180:183]
    buffer_store_dwordx4 v[136:139], v13, s[28:31], s65 offen nt
    v_mfma_f32_16x16x32_bf16 v[192:195], v[52:55], v[16:19], v[192:195]
    s_add_u32 s65, s65, 28672
    v_mfma_f32_16x16x32_bf16 v[196:199], v[52:55], v[20:23], v[196:199]
    buffer_store_dwordx4 v[152:155], v13, s[28:31], s65 offen nt
    v_mfma_f32_16x16x32_bf16 v[208:211], v[56:59], v[16:19], v[208:211]
    s_add_u32 s65, s65, 28672
    v_mfma_f32_16x16x32_bf16 v[212:215], v[56:59], v[20:23], v[212:215]
    s_waitcnt lgkmcnt(0)
    v_mfma_f32_16x16x32_bf16 v[112:115], v[76:79], v[60:63], v[112:115]
    buffer_store_dwordx4 v[108:111], v13, s[28:31], s65 offen nt
    v_mfma_f32_16x16x32_bf16 v[116:119], v[76:79], v[64:67], v[116:119]
    s_add_u32 s65, s65, 28672
    v_mfma_f32_16x16x32_bf16 v[128:131], v[80:83], v[60:63], v[128:131]
    v_mfma_f32_16x16x32_bf16 v[132:135], v[80:83], v[64:67], v[132:135]
    buffer_store_dwordx4 v[124:127], v13, s[28:31], s65 offen nt
    v_mfma_f32_16x16x32_bf16 v[144:147], v[84:87], v[60:63], v[144:147]
    v_mfma_f32_16x16x32_bf16 v[148:151], v[84:87], v[64:67], v[148:151]
    s_add_u32 s65, s65, 28672
    v_mfma_f32_16x16x32_bf16 v[160:163], v[88:91], v[60:63], v[160:163]
    v_mfma_f32_16x16x32_bf16 v[164:167], v[88:91], v[64:67], v[164:167]
    buffer_store_dwordx4 v[140:143], v13, s[28:31], s65 offen nt
    v_mfma_f32_16x16x32_bf16 v[176:179], v[92:95], v[60:63], v[176:179]
    s_add_u32 s65, s65, 28672
    v_mfma_f32_16x16x32_bf16 v[180:183], v[92:95], v[64:67], v[180:183]
    v_mfma_f32_16x16x32_bf16 v[192:195], v[96:99], v[60:63], v[192:195]
    buffer_store_dwordx4 v[156:159], v13, s[28:31], s65 offen nt
    v_mfma_f32_16x16x32_bf16 v[196:199], v[96:99], v[64:67], v[196:199]
    v_mfma_f32_16x16x32_bf16 v[208:211], v[100:103], v[60:63], v[208:211]
    s_add_u32 s65, s65, 28672
    v_mfma_f32_16x16x32_bf16 v[212:215], v[100:103], v[64:67], v[212:215]
    s_nop 7
    v_cvt_pk_bf16_f32 v216, v112, v113
    v_cvt_pk_bf16_f32 v217, v114, v115
    ds_write_b64 v10, v[216:217] offset:0
    v_cvt_pk_bf16_f32 v218, v128, v129
    v_cvt_pk_bf16_f32 v219, v130, v131
    ds_write_b64 v10, v[218:219] offset:32
    v_cvt_pk_bf16_f32 v220, v144, v145
    v_cvt_pk_bf16_f32 v221, v146, v147
    ds_write_b64 v10, v[220:221] offset:64
    v_cvt_pk_bf16_f32 v222, v160, v161
    v_cvt_pk_bf16_f32 v223, v162, v163
    ds_write_b64 v10, v[222:223] offset:96
    v_cvt_pk_bf16_f32 v224, v176, v177
    v_cvt_pk_bf16_f32 v225, v178, v179
    ds_write_b64 v10, v[224:225] offset:128
    v_cvt_pk_bf16_f32 v226, v192, v193
    v_cvt_pk_bf16_f32 v227, v194, v195
    ds_write_b64 v10, v[226:227] offset:160
    v_cvt_pk_bf16_f32 v228, v208, v209
    v_cvt_pk_bf16_f32 v229, v210, v211
    ds_write_b64 v10, v[228:229] offset:192
    ds_read_b128 v[112:115], v12 offset:0
    ds_read_b128 v[128:131], v12 offset:960
    ds_read_b128 v[144:147], v12 offset:1920
    ds_read_b128 v[160:163], v12 offset:2880
    v_cvt_pk_bf16_f32 v230, v116, v117
    v_cvt_pk_bf16_f32 v231, v118, v119
    ds_write_b64 v10, v[230:231] offset:3840
    v_cvt_pk_bf16_f32 v232, v132, v133
    v_cvt_pk_bf16_f32 v233, v134, v135
    ds_write_b64 v10, v[232:233] offset:3872
    v_cvt_pk_bf16_f32 v234, v148, v149
    v_cvt_pk_bf16_f32 v235, v150, v151
    ds_write_b64 v10, v[234:235] offset:3904
    v_cvt_pk_bf16_f32 v236, v164, v165
    v_cvt_pk_bf16_f32 v237, v166, v167
    ds_write_b64 v10, v[236:237] offset:3936
    v_cvt_pk_bf16_f32 v238, v180, v181
    v_cvt_pk_bf16_f32 v239, v182, v183
    ds_write_b64 v10, v[238:239] offset:3968
    v_cvt_pk_bf16_f32 v240, v196, v197
    v_cvt_pk_bf16_f32 v241, v198, v199
    ds_write_b64 v10, v[240:241] offset:4000
    v_cvt_pk_bf16_f32 v242, v212, v213
    v_cvt_pk_bf16_f32 v243, v214, v215
    ds_write_b64 v10, v[242:243] offset:4032
    s_waitcnt lgkmcnt(10)
    buffer_store_dwordx4 v[112:115], v13, s[28:31], s65 offen
    s_add_u32 s65, s65, 28672
    s_waitcnt lgkmcnt(9)
    buffer_store_dwordx4 v[128:131], v13, s[28:31], s65 offen
    s_add_u32 s65, s65, 28672
    s_waitcnt lgkmcnt(8)
    buffer_store_dwordx4 v[144:147], v13, s[28:31], s65 offen
    s_add_u32 s65, s65, 28672
    s_waitcnt lgkmcnt(7)
    buffer_store_dwordx4 v[160:163], v13, s[28:31], s65 offen
    s_add_u32 s65, s65, 28672
    ds_read_b128 v[116:119], v12 offset:3840
    ds_read_b128 v[132:135], v12 offset:4800
    ds_read_b128 v[148:151], v12 offset:5760
    ds_read_b128 v[164:167], v12 offset:6720
    s_waitcnt lgkmcnt(3)
    buffer_store_dwordx4 v[116:119], v13, s[28:31], s65 offen
    s_add_u32 s65, s65, 28672
    s_waitcnt lgkmcnt(2)
    buffer_store_dwordx4 v[132:135], v13, s[28:31], s65 offen
    s_add_u32 s65, s65, 28672
    s_waitcnt lgkmcnt(1)
    buffer_store_dwordx4 v[148:151], v13, s[28:31], s65 offen
    s_add_u32 s65, s65, 28672
    s_waitcnt lgkmcnt(0)
    buffer_store_dwordx4 v[164:167], v13, s[28:31], s65 offen
    s_add_u32 s65, s65, 28672
    s_endpgm
.p2align 6
L_load:
    s_cmp_lg_u32 s14, 7
    s_cbranch_scc1 L_noipf
    s_getpc_b64 s[40:41]
L_pc:
    s_sub_u32 s40, s40, L_pc-standalone__normalfloat_lut_codebook_lookup__prompt_kernel
    s_subb_u32 s41, s41, 0
    v_lshlrev_b32 v124, 7, v0
    v_cmp_gt_u32 vcc, L_codeend-standalone__normalfloat_lut_codebook_lookup__prompt_kernel, v124
    s_nop 1
    s_mov_b64 exec, vcc
    global_load_dword v128, v124, s[40:41]
    s_mov_b64 exec, -1
    v_add_u32 v124, 8192, v124
    v_cmp_gt_u32 vcc, L_codeend-standalone__normalfloat_lut_codebook_lookup__prompt_kernel, v124
    s_cbranch_vccz L_noipf
    s_mov_b64 exec, vcc
    global_load_dword v128, v124, s[40:41]
    s_mov_b64 exec, -1
L_noipf:
    v_lshlrev_b32 v104, 4, v0
    v_lshrrev_b32 v124, 3, v0
    v_and_b32 v125, 7, v0
    v_lshrrev_b32 v126, 4, v0
    v_xor_b32 v125, v125, v126
    v_lshlrev_b32 v125, 4, v125
    v_lshl_add_u32 v125, v124, 11, v125
    v_xor_b32 v126, 64, v125
    v_add_u32 v106, 0, v125
    v_add_u32 v107, 15360, v126
    v_add_u32 v108, 30720, v125
    v_add_u32 v109, 46080, v126
    v_add_u32 v110, 65536, v125
    v_add_u32 v111, 80896, v126
    v_add_u32 v112, 96256, v125
    v_add_u32 v113, 111616, v126
    s_lshl_b32 s72, s15, 13
    s_lshl_b32 s83, s15, 6
    s_add_u32 s83, s83, s56
    s_lshl_b32 s83, s83, 11
    s_add_u32 s58, s83, s56
    s_add_u32 s58, s58, 128
    v_lshlrev_b32 v114, 3, v0
    v_lshlrev_b32 v124, 7, v0
    s_add_u32 m0, s72, 47104
    s_lshl_b32 s65, s81, 1
    s_lshl_b32 s30, 3, s65
    s_mov_b32 s66, 0
    s_mov_b32 s31, 0
    s_lshl_b32 s65, s2, 14
    s_and_b32 s71, s14, 1
    s_lshl_b32 s71, s71, 13
    s_add_u32 s60, s65, s71
    s_waitcnt lgkmcnt(0)
    s_load_dwordx8 s[88:95], s[8:9], 0
    s_mov_b32 s16, s4
    s_and_b32 s17, s5, 0xffff
    s_mov_b32 s18, 4194304
    s_mov_b32 s19, 0x20000
    s_mov_b32 s20, s6
    s_and_b32 s21, s7, 0xffff
    s_mov_b32 s22, 14680064
    s_mov_b32 s23, 0x74fac
    s_mov_b32 s24, s10
    s_and_b32 s25, s11, 0xffff
    s_mov_b32 s26, 57344
    s_mov_b32 s27, 0x20000
    s_mov_b32 s32, s38
    s_and_b32 s33, s39, 0xffff
    s_mov_b32 s34, 7348224
    s_mov_b32 s35, 0x20000
    s_and_b32 s37, s37, 0xffff
    s_mov_b32 s38, 256
    s_mov_b32 s39, 0x20000
    s_barrier
    buffer_load_dwordx2 v[252:253], v9, s[32:35], s84 offen offset:128
    s_cmp_lt_u32 s14, 6
    s_cselect_b64 exec, 1, -1
    buffer_load_dword v129, v124, s[16:19], s60 offen
    s_mov_b64 exec, -1
    buffer_load_format_d16_xyzw v[48:49], v8, s[20:23], s59 offen
    s_add_u32 s59, s59, 14336
    buffer_load_format_d16_xyzw v[50:51], v8, s[20:23], s59 offen
    s_add_u32 s59, s59, 14336
    buffer_load_format_d16_xyzw v[52:53], v8, s[20:23], s59 offen
    s_add_u32 s59, s59, 14336
    buffer_load_format_d16_xyzw v[54:55], v8, s[20:23], s59 offen
    s_add_u32 s59, s59, 14336
    buffer_load_format_d16_xyzw v[56:57], v8, s[20:23], s59 offen
    s_add_u32 s59, s59, 14336
    buffer_load_format_d16_xyzw v[58:59], v8, s[20:23], s59 offen
    s_add_u32 s59, s59, 14336
    buffer_load_format_d16_xyzw v[60:61], v8, s[20:23], s59 offen
    s_add_u32 s59, s59, 14336
    buffer_load_format_d16_xyzw v[62:63], v8, s[20:23], s59 offen
    v_mul_u32_u24 v11, 1792, v7
    v_lshrrev_b32 v12, 2, v6
    v_lshl_add_u32 v11, v12, 8, v11
    v_and_b32 v12, 3, v6
    v_lshl_add_u32 v11, v12, 4, v11
    s_mul_i32 s85, s82, 229376
    s_mul_i32 s59, s73, 14336
    s_add_u32 s59, s59, s85
    s_mul_i32 s65, s15, 3584
    s_add_u32 s59, s59, s65
    s_lshr_b32 s71, s14, 2
    s_mul_i32 s71, s71, 47104
    s_add_u32 s65, s65, s71
    s_add_u32 s65, s65, 32768
    v_lshlrev_b32 v67, 4, v0
    v_add_u32 v66, s65, v67
    v_lshlrev_b32 v12, 4, v6
    v_add_u32 v12, 141376, v12
    s_mov_b32 s62, 0x05010400
    s_mov_b32 s63, 0x07030602
    s_mov_b32 s64, 0x08080808
    s_mov_b32 s69, 0x05040100
    s_mov_b32 s3, 0x07060302
    s_mov_b32 s78, 0x06040200
    s_mov_b32 s79, 0x07050301
    s_mov_b32 s75, 0x0b0a0c0c
    s_mov_b32 s76, 0x0c0c090c
    s_mov_b32 s77, 0x0c0c0c08
    s_mov_b32 s80, 0xffffff00
    v_add_u32 v10, 79872, v11
    s_mul_i32 s65, s15, 3584
    s_add_u32 s29, s85, s65
    s_add_u32 s28, s65, 32768
    s_add_u32 s65, s65, 3584
    v_add_u32 v132, s65, v12
    s_waitcnt lgkmcnt(0)
    s_lshl_b32 s40, s88, 16
    s_and_b32 s41, s88, 0xffff0000
    s_lshl_b32 s42, s89, 16
    s_and_b32 s43, s89, 0xffff0000
    s_lshl_b32 s44, s90, 16
    s_and_b32 s45, s90, 0xffff0000
    s_lshl_b32 s46, s91, 16
    s_and_b32 s47, s91, 0xffff0000
    s_lshl_b32 s48, s92, 16
    s_and_b32 s49, s92, 0xffff0000
    s_lshl_b32 s50, s93, 16
    s_and_b32 s51, s93, 0xffff0000
    s_lshl_b32 s52, s94, 16
    s_and_b32 s53, s94, 0xffff0000
    s_lshl_b32 s54, s95, 16
    s_and_b32 s55, s95, 0xffff0000
    s_getreg_b32 s91, hwreg(HW_REG_XCC_ID, 0, 4)
    s_mov_b32 s90, 40
    s_barrier
    ds_read_b128 v[16:19], v12 offset:0
    ds_read_b128 v[20:23], v12 offset:448
    ds_read_b128 v[24:27], v12 offset:896
    ds_read_b128 v[28:31], v12 offset:1344
    ds_read_b128 v[32:35], v12 offset:1792
    ds_read_b128 v[36:39], v12 offset:2240
    ds_read_b128 v[40:43], v12 offset:2688
    ds_read_b128 v[44:47], v12 offset:3136
    s_mov_b32 s67, 1
    s_mov_b32 s70, 0
    s_mov_b32 s68, 0
    s_setprio 3
    s_waitcnt vmcnt(0)
    s_mov_b32 s65, 0x9e3779b1
    s_mov_b32 s71, 0x85ebca77
    v_mul_lo_u32 v254, v252, s65
    v_mul_lo_u32 v255, v253, s71
    v_add_u32 v254, 0x7f4a7c15, v254
    v_add_u32 v255, 0x165667b1, v255
    v_alignbit_b32 v252, v254, v254, 13
    v_xor_b32 v253, v255, v252
    v_xor_b32 v252, v252, v255
    v_and_b32 v252, -16, v252
    v_or_b32 v252, s91, v252
    s_waitcnt lgkmcnt(0)
    s_branch L_dq
L_ldq:
    s_mov_b32 s95, s59
    s_barrier
    s_setprio 0
    s_mov_b64 exec, 0xffff
    buffer_load_dwordx2 v[120:121], v114, s[32:35], s84 offen sc1
    s_mov_b64 exec, -1
    s_add_u32 s70, s70, 1
    s_cmp_eq_u32 s70, 8
    s_cselect_b32 s70, 1, s70
    s_addc_u32 s68, s68, 0
    s_add_u32 s73, s81, s70
    s_and_b32 s73, s73, 7
    s_lshl1_add_u32 s73, s73, s68
    s_lshl_b32 s58, s73, 7
    s_add_u32 s58, s58, s83
    s_add_u32 m0, s72, 94208
    s_nop 0
    buffer_load_dwordx4 v106, s[16:19], s58 offen offset:0  lds
    buffer_load_dwordx4 v107, s[16:19], s58 offen offset:1024  lds
    buffer_load_dwordx4 v108, s[16:19], s58 offen offset:2048  lds
    buffer_load_dwordx4 v109, s[16:19], s58 offen offset:3072  lds
    s_add_u32 m0, m0, 4096
    s_nop 0
    buffer_load_dwordx4 v110, s[16:19], s58 offen offset:0  lds
    buffer_load_dwordx4 v111, s[16:19], s58 offen offset:1024  lds
    buffer_load_dwordx4 v112, s[16:19], s58 offen offset:2048  lds
    buffer_load_dwordx4 v113, s[16:19], s58 offen offset:3072  lds
    s_mov_b32 s60, 94208
    s_waitcnt vmcnt(8)
    s_mov_b64 exec, 0xffff
    v_xor_b32 v122, v120, v252
    v_xor_b32 v123, v121, v253
    v_cmp_eq_u64 vcc, 0, v[122:123]
    s_or_b32 s66, s66, vcc_lo
    v_cmp_gt_u64 vcc, 16, v[122:123]
    s_mov_b64 exec, -1
    s_or_b32 s31, s31, vcc_lo
    s_mov_b32 s88, 1
    s_bitcmp1_b32 s66, s73
    s_cbranch_scc0 L_late
    s_mul_i32 s59, s73, 14336
    s_add_u32 s59, s59, s29
    s_add_u32 m0, 94208, s28
    s_nop 0
    buffer_load_dwordx4 v104, s[32:35], s59 offen offset:0  lds
    buffer_load_dwordx4 v104, s[32:35], s59 offen offset:1024  lds
    buffer_load_dwordx4 v104, s[32:35], s59 offen offset:2048  lds
    s_mov_b32 exec_hi, 0
    buffer_load_dwordx4 v104, s[32:35], s59 offen offset:3072  lds
    s_mov_b32 exec_hi, -1
    s_mov_b32 s88, 0
L_late:
    s_waitcnt lgkmcnt(0)
    s_barrier
    buffer_store_dwordx4 v[16:19], v67, s[32:35], s95 offen offset:0
    buffer_store_dwordx4 v[20:23], v67, s[32:35], s95 offen offset:1024
    buffer_store_dwordx4 v[24:27], v67, s[32:35], s95 offen offset:2048
    s_mov_b32 exec_hi, 0
    buffer_store_dwordx4 v[28:31], v67, s[32:35], s95 offen offset:3072
    s_mov_b32 exec_hi, -1
    s_cmp_eq_u32 s88, 0
    s_cbranch_scc1 L_go
    s_bitcmp1_b32 s66, s73
    s_mov_b32 s89, 0
    s_cbranch_scc0 L_slow
L_fast0:
    s_mul_i32 s59, s73, 14336
    s_add_u32 s59, s59, s29
    s_add_u32 m0, s60, s28
    s_nop 0
    buffer_load_dwordx4 v104, s[32:35], s59 offen offset:0  lds
    buffer_load_dwordx4 v104, s[32:35], s59 offen offset:1024  lds
    buffer_load_dwordx4 v104, s[32:35], s59 offen offset:2048  lds
    s_mov_b32 exec_hi, 0
    buffer_load_dwordx4 v104, s[32:35], s59 offen offset:3072  lds
    s_mov_b32 exec_hi, -1
L_got0:
L_go:
    s_mov_b64 exec, 0xffff
    buffer_load_dwordx2 v[120:121], v114, s[32:35], s84 offen sc1
    s_mov_b64 exec, -1
    s_mov_b32 s60, 0
    s_mov_b32 s61, 1
.p2align 6
L_lloop:
    s_add_u32 s70, s70, 1
    s_cmp_eq_u32 s70, 8
    s_cselect_b32 s70, 1, s70
    s_addc_u32 s68, s68, 0
    s_add_u32 s73, s81, s70
    s_and_b32 s73, s73, 7
    s_lshl1_add_u32 s73, s73, s68
    s_lshl_b32 s58, s73, 7
    s_add_u32 s58, s58, s83
    s_add_u32 m0, s60, s72
    s_nop 0
    buffer_load_dwordx4 v106, s[16:19], s58 offen offset:0  lds
    buffer_load_dwordx4 v107, s[16:19], s58 offen offset:1024  lds
    buffer_load_dwordx4 v108, s[16:19], s58 offen offset:2048  lds
    buffer_load_dwordx4 v109, s[16:19], s58 offen offset:3072  lds
    s_add_u32 m0, m0, 4096
    s_nop 0
    buffer_load_dwordx4 v110, s[16:19], s58 offen offset:0  lds
    buffer_load_dwordx4 v111, s[16:19], s58 offen offset:1024  lds
    buffer_load_dwordx4 v112, s[16:19], s58 offen offset:2048  lds
    buffer_load_dwordx4 v113, s[16:19], s58 offen offset:3072  lds
    s_bitcmp1_b32 s66, s73
    s_mov_b32 s89, 1
    s_cbranch_scc0 L_slow
L_fast1:
    s_mul_i32 s59, s73, 14336
    s_add_u32 s59, s59, s29
    s_add_u32 m0, s60, s28
    s_nop 0
    buffer_load_dwordx4 v104, s[32:35], s59 offen offset:0  lds
    buffer_load_dwordx4 v104, s[32:35], s59 offen offset:1024  lds
    buffer_load_dwordx4 v104, s[32:35], s59 offen offset:2048  lds
    s_mov_b32 exec_hi, 0
    buffer_load_dwordx4 v104, s[32:35], s59 offen offset:3072  lds
    s_mov_b32 exec_hi, -1
L_got1:
    s_add_u32 s60, s60, 47104
    s_cmp_eq_u32 s60, 141312
    s_cselect_b32 s60, 0, s60
    s_or_b32 s65, s31, s30
    s_cmp_eq_u32 s65, 0xffff
    s_waitcnt vmcnt(12)
    s_cbranch_scc1 L_allup
    s_mov_b64 exec, 0xffff
    v_xor_b32 v122, v120, v252
    v_xor_b32 v123, v121, v253
    v_cmp_eq_u64 vcc, 0, v[122:123]
    s_or_b32 s66, s66, vcc_lo
    v_cmp_gt_u64 vcc, 16, v[122:123]
    s_mov_b64 exec, -1
    s_or_b32 s31, s31, vcc_lo
    s_mov_b64 exec, 0xffff
    buffer_load_dwordx2 v[120:121], v114, s[32:35], s84 offen sc1
    s_mov_b64 exec, -1
L_allup:
    s_barrier
    s_lshl_b32 s65, s61, 3
    s_add_u32 s65, s65, s14
    s_cmp_lg_u32 s65, 12
    s_cbranch_scc1 L_nofb
    s_lshl_b32 s65, s81, 4
    s_add_u32 s65, s65, s84
    s_mov_b64 exec, 1
    buffer_store_dwordx2 v[252:253], v9, s[32:35], s65 offen offset:8
    s_mov_b64 exec, -1
L_nofb:
    s_add_u32 s61, s61, 1
    s_cmp_lt_u32 s61, 14
    s_cbranch_scc1 L_lloop
    s_cmp_lg_u32 s14, 4
    s_cbranch_scc1 L_noep
    s_lshl_b32 s65, s82, 2
    v_mov_b32 v124, 1
    s_mov_b64 exec, 1
    buffer_atomic_add v124, v9, s[36:39], s65 offen sc0 sc1
    s_waitcnt vmcnt(1)
    s_barrier
    s_waitcnt vmcnt(0)
    v_cmp_eq_u32 vcc, 7, v124
    s_cbranch_vccz L_fin
    buffer_store_dwordx2 v[252:253], v9, s[32:35], s84 offen offset:128
    s_branch L_fin
L_noep:
    s_waitcnt vmcnt(0)
    s_barrier
L_fin:
    s_endpgm
L_slow:
    s_bitcmp1_b32 s31, s73
    s_cbranch_scc1 L_fb
    s_mov_b32 s74, s90
L_poll:
    s_mov_b64 exec, 0xffff
    buffer_load_dwordx2 v[120:121], v114, s[32:35], s84 offen sc1
    s_mov_b64 exec, -1
    s_waitcnt vmcnt(0)
    s_mov_b64 exec, 0xffff
    v_xor_b32 v122, v120, v252
    v_xor_b32 v123, v121, v253
    v_cmp_eq_u64 vcc, 0, v[122:123]
    s_or_b32 s66, s66, vcc_lo
    v_cmp_gt_u64 vcc, 16, v[122:123]
    s_mov_b64 exec, -1
    s_or_b32 s31, s31, vcc_lo
    s_bitcmp1_b32 s66, s73
    s_cbranch_scc1 L_back
    s_bitcmp1_b32 s31, s73
    s_cbranch_scc1 L_fb
    s_sub_u32 s74, s74, 1
    s_cbranch_scc1 L_to
    s_sleep 2
    s_branch L_poll
L_back:
    s_cmp_eq_u32 s89, 0
    s_cbranch_scc1 L_fast0
    s_branch L_fast1
L_to:
    s_mov_b32 s90, 0
L_fb:
    s_mul_i32 s59, s73, 917504
    s_lshl_b32 s65, s57, 2
    s_add_u32 s59, s59, s65
    buffer_load_format_d16_xyzw v[48:49], v8, s[20:23], s59 offen
    s_add_u32 s59, s59, 14336
    buffer_load_format_d16_xyzw v[50:51], v8, s[20:23], s59 offen
    s_add_u32 s59, s59, 14336
    buffer_load_format_d16_xyzw v[52:53], v8, s[20:23], s59 offen
    s_add_u32 s59, s59, 14336
    buffer_load_format_d16_xyzw v[54:55], v8, s[20:23], s59 offen
    s_add_u32 s59, s59, 14336
    buffer_load_format_d16_xyzw v[56:57], v8, s[20:23], s59 offen
    s_add_u32 s59, s59, 14336
    buffer_load_format_d16_xyzw v[58:59], v8, s[20:23], s59 offen
    s_add_u32 s59, s59, 14336
    buffer_load_format_d16_xyzw v[60:61], v8, s[20:23], s59 offen
    s_add_u32 s59, s59, 14336
    buffer_load_format_d16_xyzw v[62:63], v8, s[20:23], s59 offen
    s_lshr_b32 s65, s73, 1
    s_mul_i32 s92, s65, 7168
    s_lshl_b32 s65, s57, 1
    s_add_u32 s92, s92, s65
    v_mov_b32 v64, v132
    s_mov_b32 s88, 0
    s_mov_b32 s67, 2
L_fbl:
    buffer_load_ushort v218, v65, s[24:27], s92 offen
    s_waitcnt vmcnt(0)
    s_branch L_tb
L_fbt:
    v_add_u32 v64, 896, v64
    s_add_u32 s92, s92, 2
    s_add_u32 s88, s88, 1
    s_cmp_lt_u32 s88, 4
    s_cbranch_scc1 L_fbl
    v_mov_b32 v12, v132
    ds_read_b128 v[16:19], v12 offset:0
    ds_read_b128 v[20:23], v12 offset:448
    ds_read_b128 v[24:27], v12 offset:896
    ds_read_b128 v[28:31], v12 offset:1344
    ds_read_b128 v[32:35], v12 offset:1792
    ds_read_b128 v[36:39], v12 offset:2240
    ds_read_b128 v[40:43], v12 offset:2688
    ds_read_b128 v[44:47], v12 offset:3136
    s_add_u32 s65, s60, 32768
    v_add_u32 v10, s65, v11
    s_waitcnt lgkmcnt(0)
    s_branch L_dq
L_fbd:
    s_waitcnt lgkmcnt(0)
    s_cmp_eq_u32 s89, 0
    s_cbranch_scc1 L_got0
    s_branch L_got1
L_end:
    s_endpgm
L_codeend:
.section .rodata,"a"
.p2align 6
.amdhsa_kernel standalone__normalfloat_lut_codebook_lookup__prompt_kernel
  .amdhsa_next_free_vgpr 256
  .amdhsa_next_free_sgpr 102
  .amdhsa_accum_offset 256
  .amdhsa_group_segment_fixed_size 0
  .amdhsa_kernarg_size 56
  .amdhsa_user_sgpr_count 2
  .amdhsa_user_sgpr_kernarg_segment_ptr 1
  .amdhsa_system_sgpr_workgroup_id_x 1
  .amdhsa_float_denorm_mode_32 3
.end_amdhsa_kernel
```
